```python
import torch

def _softmax(x, axis=-1):
    return torch.softmax(x, dim=axis)

def _gelu(x):
    return torch.nn.functional.gelu(x, approximate='tanh')

def _silu(x):
    return torch.nn.functional.silu(x)

def _sigmoid(x):
    return torch.sigmoid(x)

def _layernorm(x, axis=-1, eps=1e-05):
    m = x.mean(dim=axis, keepdim=True)
    v = x.var(dim=axis, keepdim=True, unbiased=False)
    return (x - m) / torch.sqrt(v + eps)

def _scatter_add(tgt, idx, src, axis=0):
    return tgt.clone().index_add_(axis, idx, src)

def _segment_sum(src, seg, n):
    out = torch.zeros((n,) + src.shape[1:], dtype=src.dtype)
    return out.index_add_(0, seg, src)

def _pad(x, pw):
    flat = tuple((v for pair in reversed(pw) for v in pair))
    return torch.nn.functional.pad(x, flat)
kernel_name = 'standalone__tree_speculative_verify_tree_attention_over_candidate_token_tree__decode'

def setup_inputs():

    _w = lambda a: (lambda t: t.to(torch.bfloat16) if t.is_floating_point() else t)(torch.as_tensor(a))
    B, Hq, Hkv, T, C, D = (1, 32, 32, 1, 16384, 128)
    tree_mask = torch.zeros((B, T, T), dtype=float)
    for b in range(B):
        parent = torch.zeros(T, dtype=torch.int64)
        for i in range(1, T):
            parent[i] = int(torch.randint(0, i, (1,)).item())
        for i in range(T):
            j = i
            tree_mask[b, i, j] = 1.0
            while j > 0:
                j = parent[j]
                tree_mask[b, i, j] = 1.0
    return {'q': _w((lambda *s: torch.randn(*s, dtype=torch.bfloat16) * 0.8)(B, Hq, T, D)), 'k_cache': _w((lambda *s: torch.randn(*s, dtype=torch.bfloat16) * 0.8)(B, Hkv, C, D)), 'v_cache': _w((lambda *s: torch.randn(*s, dtype=torch.bfloat16) * 0.05)(B, Hkv, C, D)), 'k_tree': _w((lambda *s: torch.randn(*s, dtype=torch.bfloat16) * 0.8)(B, Hkv, T, D)), 'v_tree': _w((lambda *s: torch.randn(*s, dtype=torch.bfloat16) * 0.05)(B, Hkv, T, D)), 'tree_mask': _w(tree_mask)}

def reference(q, k_cache, v_cache, k_tree, v_tree, tree_mask):
    B, Hq, T, D = q.shape
    Hkv, C = (k_cache.shape[1], k_cache.shape[2])
    rep = Hq // Hkv
    kc = (lambda x, n, axis: torch.repeat_interleave(x, n, dim=axis))(k_cache, rep, axis=1)
    vc = (lambda x, n, axis: torch.repeat_interleave(x, n, dim=axis))(v_cache, rep, axis=1)
    kt = (lambda x, n, axis: torch.repeat_interleave(x, n, dim=axis))(k_tree, rep, axis=1)
    vt = (lambda x, n, axis: torch.repeat_interleave(x, n, dim=axis))(v_tree, rep, axis=1)
    k = torch.concatenate([kc, kt], axis=2)
    v = torch.concatenate([vc, vt], axis=2)
    scale = D ** (-0.5)
    scores = torch.einsum('bhqd,bhkd->bhqk', q, k) * scale
    ctx_mask = torch.ones((B, 1, T, C), dtype=scores.dtype)
    tm = tree_mask[:, None, :, :].clone()
    full_mask = torch.concatenate([ctx_mask, tm], axis=-1)
    scores = scores + (1.0 - full_mask) * -1000000000.0
    p = _softmax(scores, axis=-1)
    return torch.einsum('bhqk,bhkd->bhqd', p, v)
```

```asm
; @launch grid=(256,1,1) block=(256,1,1) lds=98304
.amdgcn_target "amdgcn-amd-amdhsa--gfx950"
.text
.globl standalone__tree_speculative_verify_tree_attention_over_candidate_token_tree__decode_kernel
.p2align 8
.type standalone__tree_speculative_verify_tree_attention_over_candidate_token_tree__decode_kernel,@function
standalone__tree_speculative_verify_tree_attention_over_candidate_token_tree__decode_kernel:
    s_cmp_ge_u32 s2, 256
    s_cbranch_scc1 L_exit
    s_load_dwordx16 s[16:31], s[0:1], 0
    s_load_dwordx2 s[32:33], s[0:1], 64
    v_and_b32 v3, 63, v0
    v_lshrrev_b32 v15, 6, v0
    v_and_b32 v60, 3, v3
    v_lshlrev_b32 v60, 4, v60
    v_lshrrev_b32 v59, 4, v3
    v_readfirstlane_b32 s40, v15
    v_lshl_add_u32 v65, v59, 6, v60
    v_bfe_u32 v58, v3, 2, 2
    v_lshl_add_u32 v60, v58, 8, v65
    v_and_b32 v61, 15, v3
    v_lshlrev_b32 v61, 4, v61
    v_lshl_add_u32 v61, v59, 10, v61
    s_lshr_b32 s3, s2, 3
    s_lshl_b32 s39, s3, 8
    v_add_u32 v65, s39, v65
    v_lshlrev_b32 v56, 2, v3
    v_add_u32 v56, s39, v56
    v_mov_b32 v62, 0
    v_mov_b32 v63, 1
    s_and_b32 s46, s2, 7
    s_and_b32 s39, s2, 1
    s_mul_i32 s41, s46, 128
    s_add_u32 s38, s41, 132
    s_mul_i32 s39, s39, 4
    s_add_u32 s41, s41, s39
    s_sub_u32 s38, s38, s39
    s_add_u32 s41, s41, s40
    s_mul_i32 s43, s3, 160
    s_add_u32 s42, s41, s43
    s_and_b32 s42, s42, 1023
    s_lshl_b32 s42, s42, 12
    v_add_u32 v1, s42, v60
    v_add_u32 v2, s42, v61
    s_lshl_b32 s39, s3, 22
    s_mov_b32 s34, 4096
    s_mov_b32 s6, 0x400000
    s_mov_b32 s7, 0x20000
    s_mov_b32 s10, 0x400000
    s_mov_b32 s11, 0x20000
    s_lshl_b32 s46, s3, 3
    s_waitcnt lgkmcnt(0)
    s_add_u32 s4, s18, s39
    s_addc_u32 s5, s19, 0
    global_load_dwordx4 v[48:51], v65, s[16:17]
    buffer_load_dwordx4 v[68:71], v1, s[4:7], 0 offen nt
    buffer_load_dwordx4 v[72:75], v1, s[4:7], 0 offen offset:1024 nt
    buffer_load_dwordx4 v[76:79], v1, s[4:7], 0 offen offset:2048 nt
    buffer_load_dwordx4 v[80:83], v1, s[4:7], 0 offen offset:3072 nt
    s_add_u32 s8, s20, s39
    s_addc_u32 s9, s21, 0
    buffer_load_dwordx4 v[84:87], v2, s[8:11], 0 offen nt
    buffer_load_dwordx4 v[88:91], v2, s[8:11], 0 offen offset:256 nt
    buffer_load_dwordx4 v[92:95], v2, s[8:11], 0 offen offset:512 nt
    buffer_load_dwordx4 v[96:99], v2, s[8:11], 0 offen offset:768 nt
    global_load_dwordx4 v[52:55], v65, s[22:23]
    global_load_dword v56, v56, s[24:25]
    global_load_ushort v57, v62, s[26:27]
    s_lshl_b32 s39, s3, 13
    s_add_u32 s12, s32, s39
    s_addc_u32 s13, s33, 0
    s_mov_b32 s14, 8192
    s_mov_b32 s15, 0x20000
    s_and_b32 s39, s2, 7
    s_lshl_b32 s39, s39, 10
    v_lshlrev_b32 v64, 4, v3
    v_add_u32 v64, s39, v64
    v_mov_b32 v8, 0
    v_mov_b32 v9, 0
    v_mov_b32 v10, 0
    v_mov_b32 v11, 0
    s_cmp_lg_u32 s40, 0
    s_cbranch_scc1 L_noclear
    v_mov_b32 v32, -1
    v_mov_b32 v33, -1
    v_mov_b32 v34, -1
    v_mov_b32 v35, -1
    buffer_store_dwordx4 v[32:35], v64, s[12:15], 0 offen sc1
L_noclear:
    s_add_u32 s50, s30, s46
    s_addc_u32 s51, s31, 0
    v_mov_b32 v14, 0x3e0293ee
    v_mov_b32 v13, 0xff61b1e6
    v_mov_b32 v12, 0
    v_and_b32 v40, 1, v3
    v_cmp_eq_u32 vcc, 1, v40
    v_mov_b32 v40, 0xffff
    v_mov_b32 v41, 0xffff0000
    v_cndmask_b32 v40, v40, v41, vcc
    v_bfe_u32 v41, v3, 1, 3
    v_cmp_eq_u32 vcc, 0, v41
    s_nop 1
    v_cndmask_b32 v4, 0, v40, vcc
    v_cmp_eq_u32 vcc, 1, v41
    s_nop 1
    v_cndmask_b32 v5, 0, v40, vcc
    v_cmp_eq_u32 vcc, 2, v41
    s_nop 1
    v_cndmask_b32 v6, 0, v40, vcc
    v_cmp_eq_u32 vcc, 3, v41
    s_nop 1
    v_cndmask_b32 v7, 0, v40, vcc
    v_cmp_eq_u32 vcc, 0, v58
    s_nop 1
    v_cndmask_b32 v44, 0, -1, vcc
    v_cmp_eq_u32 vcc, 1, v58
    s_nop 1
    v_cndmask_b32 v45, 0, -1, vcc
    v_cmp_eq_u32 vcc, 2, v58
    s_nop 1
    v_cndmask_b32 v46, 0, -1, vcc
    v_cmp_eq_u32 vcc, 3, v58
    s_nop 1
    v_cndmask_b32 v47, 0, -1, vcc
    s_waitcnt vmcnt(11)
    v_and_b32 v16, v48, v44
    v_and_b32 v17, v49, v44
    v_and_b32 v18, v50, v44
    v_and_b32 v19, v51, v44
    v_and_b32 v20, v48, v45
    v_and_b32 v21, v49, v45
    v_and_b32 v22, v50, v45
    v_and_b32 v23, v51, v45
    v_and_b32 v24, v48, v46
    v_and_b32 v25, v49, v46
    v_and_b32 v26, v50, v46
    v_and_b32 v27, v51, v46
    v_and_b32 v28, v48, v47
    v_and_b32 v29, v49, v47
    v_and_b32 v30, v50, v47
    v_and_b32 v31, v51, v47
    s_cmp_lg_u32 s40, 0
    s_cbranch_scc1 L_loop
    s_waitcnt vmcnt(0)
L_loop:
    s_add_u32 s41, s41, 4
    s_add_u32 s42, s41, s43
    s_and_b32 s42, s42, 1023
    s_lshl_b32 s42, s42, 12
    s_cmp_ge_u32 s41, s38
    s_cselect_b32 s42, 0x80000000, s42
    v_add_u32 v1, s42, v60
    v_add_u32 v2, s42, v61
    s_waitcnt vmcnt(4)
    v_mfma_f32_16x16x32_bf16 v[32:35], v[16:19], v[68:71], 0
    v_mfma_f32_16x16x32_bf16 v[32:35], v[20:23], v[72:75], v[32:35]
    v_mfma_f32_16x16x32_bf16 v[32:35], v[24:27], v[76:79], v[32:35]
    v_mfma_f32_16x16x32_bf16 v[32:35], v[28:31], v[80:83], v[32:35]
    s_cbranch_scc1 L_nok
    buffer_load_dwordx4 v[68:71], v1, s[4:7], 0 offen nt
    buffer_load_dwordx4 v[72:75], v1, s[4:7], 0 offen offset:1024 nt
    buffer_load_dwordx4 v[76:79], v1, s[4:7], 0 offen offset:2048 nt
    buffer_load_dwordx4 v[80:83], v1, s[4:7], 0 offen offset:3072 nt
L_nok:
    s_nop 6
    v_mov_b32_dpp v36, v32 quad_perm:[0,0,0,0] row_mask:0xf bank_mask:0xf
    s_nop 1
    v_add_f32_dpp v36, v33, v36 quad_perm:[1,1,1,1] row_mask:0xf bank_mask:0xf
    s_nop 1
    v_add_f32_dpp v36, v34, v36 quad_perm:[2,2,2,2] row_mask:0xf bank_mask:0xf
    s_nop 1
    v_add_f32_dpp v36, v35, v36 quad_perm:[3,3,3,3] row_mask:0xf bank_mask:0xf
    v_mov_b32 v15, v36
    s_nop 1
    v_max_f32_dpp v15, v15, v15 row_ror:4 row_mask:0xf bank_mask:0xf
    s_nop 1
    v_max_f32_dpp v15, v15, v15 row_ror:8 row_mask:0xf bank_mask:0xf
    s_nop 1
    v_max_f32_dpp v15, v15, v15 row_bcast:15 row_mask:0xa bank_mask:0xf
    s_nop 1
    v_max_f32_dpp v15, v15, v15 row_bcast:31 row_mask:0xc bank_mask:0xf
    s_nop 0
    v_readlane_b32 s39, v15, 63
    s_nop 1
    v_mul_f32 v15, s39, v14
    v_max_f32 v15, v15, v13
    v_sub_f32 v59, v13, v15
    v_mov_b32 v13, v15
    v_exp_f32 v59, v59
    v_fma_f32 v36, v36, v14, -v13
    v_exp_f32 v36, v36
    v_mul_f32 v12, v12, v59
    v_mul_f32 v8, v8, v59
    v_mul_f32 v9, v9, v59
    v_mul_f32 v10, v10, v59
    v_mul_f32 v11, v11, v59
    v_cvt_pk_bf16_f32 v37, v36, v36
    v_add_f32 v12, v12, v36
    s_cmp_lt_u32 s41, s38
    s_cbranch_scc1 L_more
    s_waitcnt vmcnt(0)
L_more:
    s_waitcnt vmcnt(4)
    v_and_b32_dpp v40, v37, v4 row_newbcast:0 row_mask:0xf bank_mask:0xf
    v_and_b32_dpp v41, v37, v5 row_newbcast:0 row_mask:0xf bank_mask:0xf
    v_and_b32_dpp v42, v37, v6 row_newbcast:0 row_mask:0xf bank_mask:0xf
    v_and_b32_dpp v43, v37, v7 row_newbcast:0 row_mask:0xf bank_mask:0xf
    s_nop 1
    v_mfma_f32_16x16x32_bf16 v[8:11], v[40:43], v[84:87], v[8:11]
    v_and_b32_dpp v44, v37, v4 row_newbcast:4 row_mask:0xf bank_mask:0xf
    v_and_b32_dpp v45, v37, v5 row_newbcast:4 row_mask:0xf bank_mask:0xf
    v_and_b32_dpp v46, v37, v6 row_newbcast:4 row_mask:0xf bank_mask:0xf
    v_and_b32_dpp v47, v37, v7 row_newbcast:4 row_mask:0xf bank_mask:0xf
    s_nop 1
    v_mfma_f32_16x16x32_bf16 v[8:11], v[44:47], v[88:91], v[8:11]
    v_and_b32_dpp v40, v37, v4 row_newbcast:8 row_mask:0xf bank_mask:0xf
    v_and_b32_dpp v41, v37, v5 row_newbcast:8 row_mask:0xf bank_mask:0xf
    v_and_b32_dpp v42, v37, v6 row_newbcast:8 row_mask:0xf bank_mask:0xf
    v_and_b32_dpp v43, v37, v7 row_newbcast:8 row_mask:0xf bank_mask:0xf
    s_nop 1
    v_mfma_f32_16x16x32_bf16 v[8:11], v[40:43], v[92:95], v[8:11]
    v_and_b32_dpp v44, v37, v4 row_newbcast:12 row_mask:0xf bank_mask:0xf
    v_and_b32_dpp v45, v37, v5 row_newbcast:12 row_mask:0xf bank_mask:0xf
    v_and_b32_dpp v46, v37, v6 row_newbcast:12 row_mask:0xf bank_mask:0xf
    v_and_b32_dpp v47, v37, v7 row_newbcast:12 row_mask:0xf bank_mask:0xf
    s_nop 1
    v_mfma_f32_16x16x32_bf16 v[8:11], v[44:47], v[96:99], v[8:11]
    s_cmp_ge_u32 s41, s38
    s_cbranch_scc1 L_done
    buffer_load_dwordx4 v[84:87], v2, s[8:11], 0 offen nt
    buffer_load_dwordx4 v[88:91], v2, s[8:11], 0 offen offset:256 nt
    buffer_load_dwordx4 v[92:95], v2, s[8:11], 0 offen offset:512 nt
    buffer_load_dwordx4 v[96:99], v2, s[8:11], 0 offen offset:768 nt
    s_branch L_loop
L_done:
    s_nop 7
    s_cmp_lg_u32 s40, 0
    s_cbranch_scc1 L_noticket
    v_mov_b32 v66, -1
    s_mov_b64 exec, 1
    global_atomic_add v66, v62, v63, s[50:51] sc0
    s_mov_b64 exec, -1
L_noticket:
    v_add_f32_dpp v12, v12, v12 row_ror:4 row_mask:0xf bank_mask:0xf
    v_and_b32 v15, 15, v3
    v_lshlrev_b32 v15, 5, v15
    v_add_f32_dpp v12, v12, v12 row_ror:8 row_mask:0xf bank_mask:0xf
    v_lshrrev_b32 v59, 4, v3
    v_lshl_add_u32 v15, v59, 4, v15
    v_add_f32_dpp v12, v12, v12 row_bcast:15 row_mask:0xa bank_mask:0xf
    s_lshl_b32 s46, s40, 9
    v_add_u32 v15, s46, v15
    v_add_f32_dpp v12, v12, v12 row_bcast:31 row_mask:0xc bank_mask:0xf
    s_lshl_b32 s46, s40, 3
    s_add_u32 s46, s46, 2048
    v_mov_b32 v59, s46
    v_mov_b32 v40, v13
    v_mov_b32 v41, v12
    s_mov_b32 exec_hi, 0
    ds_write_b128 v15, v[8:11]
    s_mov_b32 exec_lo, 0
    s_mov_b32 exec_hi, 0x80000000
    ds_write_b64 v59, v[40:41]
    s_mov_b64 exec, -1
    s_waitcnt lgkmcnt(0)
    s_barrier
    s_cmp_lg_u32 s40, 0
    s_cbranch_scc1 L_end
    v_lshlrev_b32 v15, 3, v3
    v_mov_b32 v59, 2048
    ds_read_b64 v[16:17], v15 offset:0
    ds_read_b64 v[18:19], v15 offset:512
    ds_read_b64 v[20:21], v15 offset:1024
    ds_read_b64 v[22:23], v15 offset:1536
    ds_read_b128 v[24:27], v59 offset:0
    ds_read_b128 v[28:31], v59 offset:16
    v_mov_b32 v58, 0
    v_dot2_f32_bf16 v58, v48, v52, v58
    v_dot2_f32_bf16 v58, v49, v53, v58
    v_dot2_f32_bf16 v58, v50, v54, v58
    v_dot2_f32_bf16 v58, v51, v55, v58
    v_lshlrev_b32 v57, 16, v57
    v_sub_f32 v57, 1.0, v57
    v_mul_f32 v57, 0xceabfb8f, v57
    v_add_f32_dpp v58, v58, v58 quad_perm:[1,0,3,2] row_mask:0xf bank_mask:0xf
    v_lshlrev_b32 v15, 4, v3
    s_nop 0
    v_add_f32_dpp v58, v58, v58 quad_perm:[2,3,0,1] row_mask:0xf bank_mask:0xf
    s_nop 1
    v_add_f32_dpp v58, v58, v58 row_bcast:15 row_mask:0xa bank_mask:0xf
    s_nop 1
    v_add_f32_dpp v58, v58, v58 row_bcast:31 row_mask:0xc bank_mask:0xf
    s_nop 0
    v_readlane_b32 s39, v58, 63
    s_nop 1
    v_fma_f32 v58, s39, v14, v57
    s_waitcnt lgkmcnt(0)
    v_mov_b32 v13, v24
    v_max_f32 v13, v13, v26
    v_max_f32 v13, v13, v28
    v_max_f32 v13, v13, v30
    v_sub_f32 v24, v24, v13
    v_sub_f32 v26, v26, v13
    v_sub_f32 v28, v28, v13
    v_sub_f32 v30, v30, v13
    v_exp_f32 v24, v24
    v_exp_f32 v26, v26
    v_exp_f32 v28, v28
    v_exp_f32 v30, v30
    v_mov_b32 v42, v13
    v_mul_f32 v43, v25, v24
    v_mul_f32 v40, v16, v24
    v_mul_f32 v41, v17, v24
    v_fmac_f32 v43, v27, v26
    v_fmac_f32 v40, v18, v26
    v_fmac_f32 v41, v19, v26
    v_fmac_f32 v43, v29, v28
    v_fmac_f32 v40, v20, v28
    v_fmac_f32 v41, v21, v28
    v_fmac_f32 v43, v31, v30
    v_fmac_f32 v40, v22, v30
    v_fmac_f32 v41, v23, v30
    v_min_u32 v40, -2, v40
    v_min_u32 v41, -2, v41
    v_min_u32 v42, -2, v42
    v_min_u32 v43, -2, v43
    buffer_store_dwordx4 v[40:43], v64, s[12:15], 0 offen sc1
    s_waitcnt vmcnt(1)
    v_readfirstlane_b32 s46, v66
    s_nop 0
    s_cmp_lg_u32 s46, -1
    s_cbranch_scc1 L_haveticket
    s_waitcnt vmcnt(0)
    v_readfirstlane_b32 s46, v66
L_haveticket:
    s_nop 0
    s_cmp_lg_u32 s46, 7
    s_cbranch_scc1 L_end
    s_mov_b32 s46, 100000
L_poll:
    buffer_load_dwordx4 v[68:71], v15, s[12:15], 0 offen sc1
    buffer_load_dwordx4 v[72:75], v15, s[12:15], 0 offen offset:1024 sc1
    buffer_load_dwordx4 v[76:79], v15, s[12:15], 0 offen offset:2048 sc1
    buffer_load_dwordx4 v[80:83], v15, s[12:15], 0 offen offset:3072 sc1
    buffer_load_dwordx4 v[84:87], v15, s[12:15], s34 offen sc1
    buffer_load_dwordx4 v[88:91], v15, s[12:15], s34 offen offset:1024 sc1
    buffer_load_dwordx4 v[92:95], v15, s[12:15], s34 offen offset:2048 sc1
    buffer_load_dwordx4 v[96:99], v15, s[12:15], s34 offen offset:3072 sc1
    v_lshlrev_b32 v40, 16, v56
    v_and_b32 v41, 0xffff0000, v56
    s_lshl_b32 s39, s3, 8
    v_lshlrev_b32 v59, 2, v3
    v_add_u32 v59, s39, v59
    s_waitcnt vmcnt(0)
    v_max_u32 v43, v68, v69
    v_max3_u32 v42, v70, v71, v72
    v_max3_u32 v43, v43, v73, v74
    v_max3_u32 v42, v42, v75, v76
    v_max3_u32 v43, v43, v77, v78
    v_max3_u32 v42, v42, v79, v80
    v_max3_u32 v43, v43, v81, v82
    v_max3_u32 v42, v42, v83, v84
    v_max3_u32 v43, v43, v85, v86
    v_max3_u32 v42, v42, v87, v88
    v_max3_u32 v43, v43, v89, v90
    v_max3_u32 v42, v42, v91, v92
    v_max3_u32 v43, v43, v93, v94
    v_max3_u32 v42, v42, v95, v96
    v_max3_u32 v43, v43, v97, v98
    v_max3_u32 v43, v43, v42, v99
    v_cmp_ne_u32 vcc, -1, v43
    s_sub_u32 s46, s46, 1
    s_cbranch_scc1 L_go
    s_cmp_eq_u64 vcc, -1
    s_cbranch_scc0 L_poll
L_go:
    v_max3_f32 v13, v58, v70, v74
    v_max3_f32 v13, v13, v78, v82
    v_max3_f32 v13, v13, v86, v90
    v_max3_f32 v13, v13, v94, v98
    v_sub_f32 v58, v58, v13
    v_sub_f32 v70, v70, v13
    v_sub_f32 v74, v74, v13
    v_sub_f32 v78, v78, v13
    v_sub_f32 v82, v82, v13
    v_sub_f32 v86, v86, v13
    v_sub_f32 v90, v90, v13
    v_sub_f32 v94, v94, v13
    v_sub_f32 v98, v98, v13
    v_exp_f32 v58, v58
    v_exp_f32 v70, v70
    v_exp_f32 v74, v74
    v_exp_f32 v78, v78
    v_exp_f32 v82, v82
    v_exp_f32 v86, v86
    v_exp_f32 v90, v90
    v_exp_f32 v94, v94
    v_exp_f32 v98, v98
    v_mul_f32 v40, v40, v58
    v_mul_f32 v41, v41, v58
    v_mov_b32 v43, v58
    v_fmac_f32 v43, v71, v70
    v_fmac_f32 v40, v68, v70
    v_fmac_f32 v41, v69, v70
    v_fmac_f32 v43, v75, v74
    v_fmac_f32 v40, v72, v74
    v_fmac_f32 v41, v73, v74
    v_fmac_f32 v43, v79, v78
    v_fmac_f32 v40, v76, v78
    v_fmac_f32 v41, v77, v78
    v_fmac_f32 v43, v83, v82
    v_fmac_f32 v40, v80, v82
    v_fmac_f32 v41, v81, v82
    v_fmac_f32 v43, v87, v86
    v_fmac_f32 v40, v84, v86
    v_fmac_f32 v41, v85, v86
    v_fmac_f32 v43, v91, v90
    v_fmac_f32 v40, v88, v90
    v_fmac_f32 v41, v89, v90
    v_fmac_f32 v43, v95, v94
    v_fmac_f32 v40, v92, v94
    v_fmac_f32 v41, v93, v94
    v_fmac_f32 v43, v99, v98
    v_fmac_f32 v40, v96, v98
    v_fmac_f32 v41, v97, v98
    v_rcp_f32 v43, v43
    s_nop 0
    v_mul_f32 v40, v40, v43
    v_mul_f32 v41, v41, v43
    v_cvt_pk_bf16_f32 v40, v40, v41
    global_store_dword v59, v40, s[28:29]
L_end:
L_exit:
    s_endpgm
.section .rodata,"a"
.p2align 6
.amdhsa_kernel standalone__tree_speculative_verify_tree_attention_over_candidate_token_tree__decode_kernel
  .amdhsa_next_free_vgpr 104
  .amdhsa_next_free_sgpr 56
  .amdhsa_accum_offset 104
  .amdhsa_group_segment_fixed_size 0
  .amdhsa_kernarg_size 72
  .amdhsa_user_sgpr_count 2
  .amdhsa_user_sgpr_kernarg_segment_ptr 1
  .amdhsa_system_sgpr_workgroup_id_x 1
  .amdhsa_float_denorm_mode_32 3
.end_amdhsa_kernel
```
